```python
import torch

def _softmax(x, axis=-1):
    return torch.softmax(x, dim=axis)
def _gelu(x):
    return torch.nn.functional.gelu(x, approximate="tanh")
def _silu(x):
    return torch.nn.functional.silu(x)
def _sigmoid(x):
    return torch.sigmoid(x)
def _layernorm(x, axis=-1, eps=1e-5):
    m = x.mean(dim=axis, keepdim=True)
    v = x.var(dim=axis, keepdim=True, unbiased=False)
    return (x - m) / torch.sqrt(v + eps)
def _scatter_add(tgt, idx, src, axis=0):
    return tgt.clone().index_add_(axis, idx, src)
def _segment_sum(src, seg, n):
    out = torch.zeros((n,) + src.shape[1:], dtype=src.dtype)
    return out.index_add_(0, seg, src)
def _pad(x, pw):
    flat = tuple(v for pair in reversed(pw) for v in pair)
    return torch.nn.functional.pad(x, flat)

kernel_name = 'standalone__rmsnorm__sampling'

def setup_inputs():

    _w = (lambda a: (lambda t: t.to(torch.bfloat16) if t.is_floating_point() else t)(torch.as_tensor(a)))
    B, S, D = 1024, 32, 448
    return {
        "x": _w((lambda *s: torch.randn(*s, dtype=torch.bfloat16) * 0.05)(B, S, D)),
        "g": _w((lambda *s: torch.randn(*s, dtype=torch.bfloat16) * 0.05)(D) + 1.0),
    }

def reference(x, g):
    rms = torch.sqrt((x * x).mean(axis=-1, keepdims=True) + 1e-6)
    return x / rms * g
```

```asm
; @launch grid=(256,1,1) block=(512,1,1) lds=7184
.amdgcn_target "amdgcn-amd-amdhsa--gfx950"
.text
.globl standalone__rmsnorm__sampling_kernel
.p2align 8
.type standalone__rmsnorm__sampling_kernel,@function
standalone__rmsnorm__sampling_kernel:
    s_load_dwordx4 s[4:7], s[0:1], 0
    s_load_dwordx2 s[8:9], s[0:1], 16
    s_cmpk_ge_u32 s2, 256
    s_cbranch_scc1 L_end
    v_lshrrev_b32 v7, 6, v0
    v_bfe_u32 v6, v0, 3, 3
    v_and_b32 v1, 7, v0
    v_readfirstlane_b32 s13, v7
    v_mul_u32_u24 v6, 896, v6
    v_lshlrev_b32 v1, 4, v1
    s_lshl_b32 s3, s13, 8
    s_add_u32 s3, s3, s2
    s_mulk_i32 s3, 14336
    v_mov_b32 v8, 0
    v_add3_u32 v2, v6, v1, s3
    ds_write_b32 v8, v8
    s_waitcnt lgkmcnt(0)
    s_barrier
    global_load_dwordx4 v[12:15], v2, s[4:5] offset:0 nt
    global_load_dwordx4 v[16:19], v2, s[4:5] offset:128 nt
    global_load_dwordx4 v[20:23], v2, s[4:5] offset:256 nt
    global_load_dwordx4 v[24:27], v2, s[4:5] offset:384 nt
    global_load_dwordx4 v[28:31], v2, s[4:5] offset:512 nt
    global_load_dwordx4 v[32:35], v2, s[4:5] offset:640 nt
    global_load_dwordx4 v[36:39], v2, s[4:5] offset:768 nt
    s_mulk_i32 s13, 896
    v_and_b32 v6, 63, v0
    s_add_u32 s13, s13, 16
    v_lshlrev_b32 v6, 4, v6
    s_mov_b32 m0, s13
    v_add_u32 v3, 7168, v2
    s_bfm_b64 s[14:15], 56, 0
    s_mov_b64 exec, s[14:15]
    global_load_lds_dwordx4 v6, s[6:7]
    s_mov_b64 exec, -1
    global_load_dwordx4 v[40:43], v3, s[4:5] offset:0 nt
    global_load_dwordx4 v[44:47], v3, s[4:5] offset:128 nt
    global_load_dwordx4 v[48:51], v3, s[4:5] offset:256 nt
    global_load_dwordx4 v[52:55], v3, s[4:5] offset:384 nt
    global_load_dwordx4 v[56:59], v3, s[4:5] offset:512 nt
    global_load_dwordx4 v[60:63], v3, s[4:5] offset:640 nt
    global_load_dwordx4 v[64:67], v3, s[4:5] offset:768 nt
    s_mov_b32 s10, 0x3b124925
    s_mov_b32 s11, 0x358637bd
    s_mov_b32 s12, 0xffff0000
    v_mov_b32 v9, 4
    v_mov_b32 v10, 3
    s_mov_b64 exec, 1
    s_waitcnt vmcnt(11)
    ds_add_u32 v8, v9
    s_waitcnt vmcnt(8)
    ds_add_u32 v8, v10
    s_waitcnt vmcnt(3)
    ds_add_u32 v8, v9
    s_waitcnt vmcnt(0)
    ds_add_u32 v8, v10
    s_mov_b64 exec, -1
    v_add_u32 v6, s13, v1
    ds_read_b128 v[96:99], v6 offset:0
    ds_read_b128 v[100:103], v6 offset:128
    ds_read_b128 v[104:107], v6 offset:256
    ds_read_b128 v[108:111], v6 offset:384
    ds_read_b128 v[112:115], v6 offset:512
    ds_read_b128 v[116:119], v6 offset:640
    ds_read_b128 v[120:123], v6 offset:768
    s_waitcnt lgkmcnt(6)
    v_lshlrev_b32 v68, 16, v96
    v_and_b32 v69, s12, v96
    v_lshlrev_b32 v70, 16, v97
    v_and_b32 v71, s12, v97
    v_lshlrev_b32 v72, 16, v98
    v_and_b32 v73, s12, v98
    v_lshlrev_b32 v74, 16, v99
    v_and_b32 v75, s12, v99
    s_waitcnt lgkmcnt(5)
    v_lshlrev_b32 v76, 16, v100
    v_and_b32 v77, s12, v100
    v_lshlrev_b32 v78, 16, v101
    v_and_b32 v79, s12, v101
    v_lshlrev_b32 v80, 16, v102
    v_and_b32 v81, s12, v102
    v_lshlrev_b32 v82, 16, v103
    v_and_b32 v83, s12, v103
    s_waitcnt lgkmcnt(4)
    v_lshlrev_b32 v84, 16, v104
    v_and_b32 v85, s12, v104
    v_lshlrev_b32 v86, 16, v105
    v_and_b32 v87, s12, v105
    v_lshlrev_b32 v88, 16, v106
    v_and_b32 v89, s12, v106
    v_lshlrev_b32 v90, 16, v107
    v_and_b32 v91, s12, v107
    s_waitcnt lgkmcnt(3)
    v_lshlrev_b32 v92, 16, v108
    v_and_b32 v93, s12, v108
    v_lshlrev_b32 v94, 16, v109
    v_and_b32 v95, s12, v109
    v_lshlrev_b32 v96, 16, v110
    v_and_b32 v97, s12, v110
    v_lshlrev_b32 v98, 16, v111
    v_and_b32 v99, s12, v111
    s_waitcnt lgkmcnt(2)
    v_lshlrev_b32 v100, 16, v112
    v_and_b32 v101, s12, v112
    v_lshlrev_b32 v102, 16, v113
    v_and_b32 v103, s12, v113
    v_lshlrev_b32 v104, 16, v114
    v_and_b32 v105, s12, v114
    v_lshlrev_b32 v106, 16, v115
    v_and_b32 v107, s12, v115
    s_waitcnt lgkmcnt(1)
    v_lshlrev_b32 v108, 16, v116
    v_and_b32 v109, s12, v116
    v_lshlrev_b32 v110, 16, v117
    v_and_b32 v111, s12, v117
    v_lshlrev_b32 v112, 16, v118
    v_and_b32 v113, s12, v118
    v_lshlrev_b32 v114, 16, v119
    v_and_b32 v115, s12, v119
    s_waitcnt lgkmcnt(0)
    v_lshlrev_b32 v116, 16, v120
    v_and_b32 v117, s12, v120
    v_lshlrev_b32 v118, 16, v121
    v_and_b32 v119, s12, v121
    v_lshlrev_b32 v120, 16, v122
    v_and_b32 v121, s12, v122
    v_lshlrev_b32 v122, 16, v123
    v_and_b32 v123, s12, v123
    v_mov_b32 v4, 0
    v_mov_b32 v5, 0
    v_dot2c_f32_bf16 v4, v12, v12
    v_dot2c_f32_bf16 v5, v13, v13
    v_dot2c_f32_bf16 v4, v14, v14
    v_dot2c_f32_bf16 v5, v15, v15
    v_dot2c_f32_bf16 v4, v16, v16
    v_dot2c_f32_bf16 v5, v17, v17
    v_dot2c_f32_bf16 v4, v18, v18
    v_dot2c_f32_bf16 v5, v19, v19
    v_dot2c_f32_bf16 v4, v20, v20
    v_dot2c_f32_bf16 v5, v21, v21
    v_dot2c_f32_bf16 v4, v22, v22
    v_dot2c_f32_bf16 v5, v23, v23
    v_dot2c_f32_bf16 v4, v24, v24
    v_dot2c_f32_bf16 v5, v25, v25
    v_dot2c_f32_bf16 v4, v26, v26
    v_dot2c_f32_bf16 v5, v27, v27
    v_dot2c_f32_bf16 v4, v28, v28
    v_dot2c_f32_bf16 v5, v29, v29
    v_dot2c_f32_bf16 v4, v30, v30
    v_dot2c_f32_bf16 v5, v31, v31
    v_dot2c_f32_bf16 v4, v32, v32
    v_dot2c_f32_bf16 v5, v33, v33
    v_dot2c_f32_bf16 v4, v34, v34
    v_dot2c_f32_bf16 v5, v35, v35
    v_dot2c_f32_bf16 v4, v36, v36
    v_dot2c_f32_bf16 v5, v37, v37
    v_dot2c_f32_bf16 v4, v38, v38
    v_dot2c_f32_bf16 v5, v39, v39
    s_nop 2
    v_add_f32 v4, v4, v5
    s_nop 1
    v_add_f32_dpp v4, v4, v4 quad_perm:[1,0,3,2] row_mask:0xf bank_mask:0xf
    s_nop 1
    v_add_f32_dpp v4, v4, v4 quad_perm:[2,3,0,1] row_mask:0xf bank_mask:0xf
    s_nop 1
    v_add_f32_dpp v4, v4, v4 row_half_mirror row_mask:0xf bank_mask:0xf
    v_mov_b32 v5, s11
    v_fmac_f32 v5, s10, v4
    v_rsq_f32 v10, v5
    v_lshlrev_b32 v6, 16, v12
    v_and_b32 v7, s12, v12
    v_pk_mul_f32 v[6:7], v[6:7], v[10:11] op_sel_hi:[1,0]
    v_pk_mul_f32 v[6:7], v[6:7], v[68:69]
    v_cvt_pk_bf16_f32 v12, v6, v7
    v_lshlrev_b32 v8, 16, v13
    v_and_b32 v9, s12, v13
    v_pk_mul_f32 v[8:9], v[8:9], v[10:11] op_sel_hi:[1,0]
    v_pk_mul_f32 v[8:9], v[8:9], v[70:71]
    v_cvt_pk_bf16_f32 v13, v8, v9
    v_lshlrev_b32 v6, 16, v14
    v_and_b32 v7, s12, v14
    v_pk_mul_f32 v[6:7], v[6:7], v[10:11] op_sel_hi:[1,0]
    v_pk_mul_f32 v[6:7], v[6:7], v[72:73]
    v_cvt_pk_bf16_f32 v14, v6, v7
    v_lshlrev_b32 v8, 16, v15
    v_and_b32 v9, s12, v15
    v_pk_mul_f32 v[8:9], v[8:9], v[10:11] op_sel_hi:[1,0]
    v_pk_mul_f32 v[8:9], v[8:9], v[74:75]
    v_cvt_pk_bf16_f32 v15, v8, v9
    v_lshlrev_b32 v6, 16, v16
    v_and_b32 v7, s12, v16
    v_pk_mul_f32 v[6:7], v[6:7], v[10:11] op_sel_hi:[1,0]
    v_pk_mul_f32 v[6:7], v[6:7], v[76:77]
    v_cvt_pk_bf16_f32 v16, v6, v7
    v_lshlrev_b32 v8, 16, v17
    v_and_b32 v9, s12, v17
    v_pk_mul_f32 v[8:9], v[8:9], v[10:11] op_sel_hi:[1,0]
    v_pk_mul_f32 v[8:9], v[8:9], v[78:79]
    v_cvt_pk_bf16_f32 v17, v8, v9
    v_lshlrev_b32 v6, 16, v18
    v_and_b32 v7, s12, v18
    v_pk_mul_f32 v[6:7], v[6:7], v[10:11] op_sel_hi:[1,0]
    v_pk_mul_f32 v[6:7], v[6:7], v[80:81]
    v_cvt_pk_bf16_f32 v18, v6, v7
    v_lshlrev_b32 v8, 16, v19
    v_and_b32 v9, s12, v19
    v_pk_mul_f32 v[8:9], v[8:9], v[10:11] op_sel_hi:[1,0]
    v_pk_mul_f32 v[8:9], v[8:9], v[82:83]
    v_cvt_pk_bf16_f32 v19, v8, v9
    v_lshlrev_b32 v6, 16, v20
    v_and_b32 v7, s12, v20
    v_pk_mul_f32 v[6:7], v[6:7], v[10:11] op_sel_hi:[1,0]
    v_pk_mul_f32 v[6:7], v[6:7], v[84:85]
    v_cvt_pk_bf16_f32 v20, v6, v7
    v_lshlrev_b32 v8, 16, v21
    v_and_b32 v9, s12, v21
    v_pk_mul_f32 v[8:9], v[8:9], v[10:11] op_sel_hi:[1,0]
    v_pk_mul_f32 v[8:9], v[8:9], v[86:87]
    v_cvt_pk_bf16_f32 v21, v8, v9
    v_lshlrev_b32 v6, 16, v22
    v_and_b32 v7, s12, v22
    v_pk_mul_f32 v[6:7], v[6:7], v[10:11] op_sel_hi:[1,0]
    v_pk_mul_f32 v[6:7], v[6:7], v[88:89]
    v_cvt_pk_bf16_f32 v22, v6, v7
    v_lshlrev_b32 v8, 16, v23
    v_and_b32 v9, s12, v23
    v_pk_mul_f32 v[8:9], v[8:9], v[10:11] op_sel_hi:[1,0]
    v_pk_mul_f32 v[8:9], v[8:9], v[90:91]
    v_cvt_pk_bf16_f32 v23, v8, v9
    v_lshlrev_b32 v6, 16, v24
    v_and_b32 v7, s12, v24
    v_pk_mul_f32 v[6:7], v[6:7], v[10:11] op_sel_hi:[1,0]
    v_pk_mul_f32 v[6:7], v[6:7], v[92:93]
    v_cvt_pk_bf16_f32 v24, v6, v7
    v_lshlrev_b32 v8, 16, v25
    v_and_b32 v9, s12, v25
    v_pk_mul_f32 v[8:9], v[8:9], v[10:11] op_sel_hi:[1,0]
    v_pk_mul_f32 v[8:9], v[8:9], v[94:95]
    v_cvt_pk_bf16_f32 v25, v8, v9
    v_lshlrev_b32 v6, 16, v26
    v_and_b32 v7, s12, v26
    v_pk_mul_f32 v[6:7], v[6:7], v[10:11] op_sel_hi:[1,0]
    v_pk_mul_f32 v[6:7], v[6:7], v[96:97]
    v_cvt_pk_bf16_f32 v26, v6, v7
    v_lshlrev_b32 v8, 16, v27
    v_and_b32 v9, s12, v27
    v_pk_mul_f32 v[8:9], v[8:9], v[10:11] op_sel_hi:[1,0]
    v_pk_mul_f32 v[8:9], v[8:9], v[98:99]
    v_cvt_pk_bf16_f32 v27, v8, v9
    v_lshlrev_b32 v6, 16, v28
    v_and_b32 v7, s12, v28
    v_pk_mul_f32 v[6:7], v[6:7], v[10:11] op_sel_hi:[1,0]
    v_pk_mul_f32 v[6:7], v[6:7], v[100:101]
    v_cvt_pk_bf16_f32 v28, v6, v7
    v_lshlrev_b32 v8, 16, v29
    v_and_b32 v9, s12, v29
    v_pk_mul_f32 v[8:9], v[8:9], v[10:11] op_sel_hi:[1,0]
    v_pk_mul_f32 v[8:9], v[8:9], v[102:103]
    v_cvt_pk_bf16_f32 v29, v8, v9
    v_lshlrev_b32 v6, 16, v30
    v_and_b32 v7, s12, v30
    v_pk_mul_f32 v[6:7], v[6:7], v[10:11] op_sel_hi:[1,0]
    v_pk_mul_f32 v[6:7], v[6:7], v[104:105]
    v_cvt_pk_bf16_f32 v30, v6, v7
    v_lshlrev_b32 v8, 16, v31
    v_and_b32 v9, s12, v31
    v_pk_mul_f32 v[8:9], v[8:9], v[10:11] op_sel_hi:[1,0]
    v_pk_mul_f32 v[8:9], v[8:9], v[106:107]
    v_cvt_pk_bf16_f32 v31, v8, v9
    v_lshlrev_b32 v6, 16, v32
    v_and_b32 v7, s12, v32
    v_pk_mul_f32 v[6:7], v[6:7], v[10:11] op_sel_hi:[1,0]
    v_pk_mul_f32 v[6:7], v[6:7], v[108:109]
    v_cvt_pk_bf16_f32 v32, v6, v7
    v_lshlrev_b32 v8, 16, v33
    v_and_b32 v9, s12, v33
    v_pk_mul_f32 v[8:9], v[8:9], v[10:11] op_sel_hi:[1,0]
    v_pk_mul_f32 v[8:9], v[8:9], v[110:111]
    v_cvt_pk_bf16_f32 v33, v8, v9
    v_lshlrev_b32 v6, 16, v34
    v_and_b32 v7, s12, v34
    v_pk_mul_f32 v[6:7], v[6:7], v[10:11] op_sel_hi:[1,0]
    v_pk_mul_f32 v[6:7], v[6:7], v[112:113]
    v_cvt_pk_bf16_f32 v34, v6, v7
    v_lshlrev_b32 v8, 16, v35
    v_and_b32 v9, s12, v35
    v_pk_mul_f32 v[8:9], v[8:9], v[10:11] op_sel_hi:[1,0]
    v_pk_mul_f32 v[8:9], v[8:9], v[114:115]
    v_cvt_pk_bf16_f32 v35, v8, v9
    v_lshlrev_b32 v6, 16, v36
    v_and_b32 v7, s12, v36
    v_pk_mul_f32 v[6:7], v[6:7], v[10:11] op_sel_hi:[1,0]
    v_pk_mul_f32 v[6:7], v[6:7], v[116:117]
    v_cvt_pk_bf16_f32 v36, v6, v7
    v_lshlrev_b32 v8, 16, v37
    v_and_b32 v9, s12, v37
    v_pk_mul_f32 v[8:9], v[8:9], v[10:11] op_sel_hi:[1,0]
    v_pk_mul_f32 v[8:9], v[8:9], v[118:119]
    v_cvt_pk_bf16_f32 v37, v8, v9
    v_lshlrev_b32 v6, 16, v38
    v_and_b32 v7, s12, v38
    v_pk_mul_f32 v[6:7], v[6:7], v[10:11] op_sel_hi:[1,0]
    v_pk_mul_f32 v[6:7], v[6:7], v[120:121]
    v_cvt_pk_bf16_f32 v38, v6, v7
    v_lshlrev_b32 v8, 16, v39
    v_and_b32 v9, s12, v39
    v_pk_mul_f32 v[8:9], v[8:9], v[10:11] op_sel_hi:[1,0]
    v_pk_mul_f32 v[8:9], v[8:9], v[122:123]
    v_cvt_pk_bf16_f32 v39, v8, v9
    v_mov_b32 v4, 0
    v_mov_b32 v5, 0
    v_dot2c_f32_bf16 v4, v40, v40
    v_dot2c_f32_bf16 v5, v41, v41
    v_dot2c_f32_bf16 v4, v42, v42
    v_dot2c_f32_bf16 v5, v43, v43
    v_dot2c_f32_bf16 v4, v44, v44
    v_dot2c_f32_bf16 v5, v45, v45
    v_dot2c_f32_bf16 v4, v46, v46
    v_dot2c_f32_bf16 v5, v47, v47
    v_dot2c_f32_bf16 v4, v48, v48
    v_dot2c_f32_bf16 v5, v49, v49
    v_dot2c_f32_bf16 v4, v50, v50
    v_dot2c_f32_bf16 v5, v51, v51
    v_dot2c_f32_bf16 v4, v52, v52
    v_dot2c_f32_bf16 v5, v53, v53
    v_dot2c_f32_bf16 v4, v54, v54
    v_dot2c_f32_bf16 v5, v55, v55
    v_dot2c_f32_bf16 v4, v56, v56
    v_dot2c_f32_bf16 v5, v57, v57
    v_dot2c_f32_bf16 v4, v58, v58
    v_dot2c_f32_bf16 v5, v59, v59
    v_dot2c_f32_bf16 v4, v60, v60
    v_dot2c_f32_bf16 v5, v61, v61
    v_dot2c_f32_bf16 v4, v62, v62
    v_dot2c_f32_bf16 v5, v63, v63
    v_dot2c_f32_bf16 v4, v64, v64
    v_dot2c_f32_bf16 v5, v65, v65
    v_dot2c_f32_bf16 v4, v66, v66
    v_dot2c_f32_bf16 v5, v67, v67
    s_nop 2
    v_add_f32 v4, v4, v5
    s_nop 1
    v_add_f32_dpp v4, v4, v4 quad_perm:[1,0,3,2] row_mask:0xf bank_mask:0xf
    s_nop 1
    v_add_f32_dpp v4, v4, v4 quad_perm:[2,3,0,1] row_mask:0xf bank_mask:0xf
    s_nop 1
    v_add_f32_dpp v4, v4, v4 row_half_mirror row_mask:0xf bank_mask:0xf
    v_mov_b32 v5, s11
    v_fmac_f32 v5, s10, v4
    v_rsq_f32 v10, v5
    v_lshlrev_b32 v6, 16, v40
    v_and_b32 v7, s12, v40
    v_pk_mul_f32 v[6:7], v[6:7], v[10:11] op_sel_hi:[1,0]
    v_pk_mul_f32 v[6:7], v[6:7], v[68:69]
    v_cvt_pk_bf16_f32 v40, v6, v7
    v_lshlrev_b32 v8, 16, v41
    v_and_b32 v9, s12, v41
    v_pk_mul_f32 v[8:9], v[8:9], v[10:11] op_sel_hi:[1,0]
    v_pk_mul_f32 v[8:9], v[8:9], v[70:71]
    v_cvt_pk_bf16_f32 v41, v8, v9
    v_lshlrev_b32 v6, 16, v42
    v_and_b32 v7, s12, v42
    v_pk_mul_f32 v[6:7], v[6:7], v[10:11] op_sel_hi:[1,0]
    v_pk_mul_f32 v[6:7], v[6:7], v[72:73]
    v_cvt_pk_bf16_f32 v42, v6, v7
    v_lshlrev_b32 v8, 16, v43
    v_and_b32 v9, s12, v43
    v_pk_mul_f32 v[8:9], v[8:9], v[10:11] op_sel_hi:[1,0]
    v_pk_mul_f32 v[8:9], v[8:9], v[74:75]
    v_cvt_pk_bf16_f32 v43, v8, v9
    v_lshlrev_b32 v6, 16, v44
    v_and_b32 v7, s12, v44
    v_pk_mul_f32 v[6:7], v[6:7], v[10:11] op_sel_hi:[1,0]
    v_pk_mul_f32 v[6:7], v[6:7], v[76:77]
    v_cvt_pk_bf16_f32 v44, v6, v7
    v_lshlrev_b32 v8, 16, v45
    v_and_b32 v9, s12, v45
    v_pk_mul_f32 v[8:9], v[8:9], v[10:11] op_sel_hi:[1,0]
    v_pk_mul_f32 v[8:9], v[8:9], v[78:79]
    v_cvt_pk_bf16_f32 v45, v8, v9
    v_lshlrev_b32 v6, 16, v46
    v_and_b32 v7, s12, v46
    v_pk_mul_f32 v[6:7], v[6:7], v[10:11] op_sel_hi:[1,0]
    v_pk_mul_f32 v[6:7], v[6:7], v[80:81]
    v_cvt_pk_bf16_f32 v46, v6, v7
    v_lshlrev_b32 v8, 16, v47
    v_and_b32 v9, s12, v47
    v_pk_mul_f32 v[8:9], v[8:9], v[10:11] op_sel_hi:[1,0]
    v_pk_mul_f32 v[8:9], v[8:9], v[82:83]
    v_cvt_pk_bf16_f32 v47, v8, v9
    v_lshlrev_b32 v6, 16, v48
    v_and_b32 v7, s12, v48
    v_pk_mul_f32 v[6:7], v[6:7], v[10:11] op_sel_hi:[1,0]
    v_pk_mul_f32 v[6:7], v[6:7], v[84:85]
    v_cvt_pk_bf16_f32 v48, v6, v7
    v_lshlrev_b32 v8, 16, v49
    v_and_b32 v9, s12, v49
    v_pk_mul_f32 v[8:9], v[8:9], v[10:11] op_sel_hi:[1,0]
    v_pk_mul_f32 v[8:9], v[8:9], v[86:87]
    v_cvt_pk_bf16_f32 v49, v8, v9
    v_lshlrev_b32 v6, 16, v50
    v_and_b32 v7, s12, v50
    v_pk_mul_f32 v[6:7], v[6:7], v[10:11] op_sel_hi:[1,0]
    v_pk_mul_f32 v[6:7], v[6:7], v[88:89]
    v_cvt_pk_bf16_f32 v50, v6, v7
    v_lshlrev_b32 v8, 16, v51
    v_and_b32 v9, s12, v51
    v_pk_mul_f32 v[8:9], v[8:9], v[10:11] op_sel_hi:[1,0]
    v_pk_mul_f32 v[8:9], v[8:9], v[90:91]
    v_cvt_pk_bf16_f32 v51, v8, v9
    v_lshlrev_b32 v6, 16, v52
    v_and_b32 v7, s12, v52
    v_pk_mul_f32 v[6:7], v[6:7], v[10:11] op_sel_hi:[1,0]
    v_pk_mul_f32 v[6:7], v[6:7], v[92:93]
    v_cvt_pk_bf16_f32 v52, v6, v7
    v_lshlrev_b32 v8, 16, v53
    v_and_b32 v9, s12, v53
    v_pk_mul_f32 v[8:9], v[8:9], v[10:11] op_sel_hi:[1,0]
    v_pk_mul_f32 v[8:9], v[8:9], v[94:95]
    v_cvt_pk_bf16_f32 v53, v8, v9
    v_lshlrev_b32 v6, 16, v54
    v_and_b32 v7, s12, v54
    v_pk_mul_f32 v[6:7], v[6:7], v[10:11] op_sel_hi:[1,0]
    v_pk_mul_f32 v[6:7], v[6:7], v[96:97]
    v_cvt_pk_bf16_f32 v54, v6, v7
    v_lshlrev_b32 v8, 16, v55
    v_and_b32 v9, s12, v55
    v_pk_mul_f32 v[8:9], v[8:9], v[10:11] op_sel_hi:[1,0]
    v_pk_mul_f32 v[8:9], v[8:9], v[98:99]
    v_cvt_pk_bf16_f32 v55, v8, v9
    v_lshlrev_b32 v6, 16, v56
    v_and_b32 v7, s12, v56
    v_pk_mul_f32 v[6:7], v[6:7], v[10:11] op_sel_hi:[1,0]
    v_pk_mul_f32 v[6:7], v[6:7], v[100:101]
    v_cvt_pk_bf16_f32 v56, v6, v7
    v_lshlrev_b32 v8, 16, v57
    v_and_b32 v9, s12, v57
    v_pk_mul_f32 v[8:9], v[8:9], v[10:11] op_sel_hi:[1,0]
    v_pk_mul_f32 v[8:9], v[8:9], v[102:103]
    v_cvt_pk_bf16_f32 v57, v8, v9
    v_lshlrev_b32 v6, 16, v58
    v_and_b32 v7, s12, v58
    v_pk_mul_f32 v[6:7], v[6:7], v[10:11] op_sel_hi:[1,0]
    v_pk_mul_f32 v[6:7], v[6:7], v[104:105]
    v_cvt_pk_bf16_f32 v58, v6, v7
    v_lshlrev_b32 v8, 16, v59
    v_and_b32 v9, s12, v59
    v_pk_mul_f32 v[8:9], v[8:9], v[10:11] op_sel_hi:[1,0]
    v_pk_mul_f32 v[8:9], v[8:9], v[106:107]
    v_cvt_pk_bf16_f32 v59, v8, v9
    v_lshlrev_b32 v6, 16, v60
    v_and_b32 v7, s12, v60
    v_pk_mul_f32 v[6:7], v[6:7], v[10:11] op_sel_hi:[1,0]
    v_pk_mul_f32 v[6:7], v[6:7], v[108:109]
    v_cvt_pk_bf16_f32 v60, v6, v7
    v_lshlrev_b32 v8, 16, v61
    v_and_b32 v9, s12, v61
    v_pk_mul_f32 v[8:9], v[8:9], v[10:11] op_sel_hi:[1,0]
    v_pk_mul_f32 v[8:9], v[8:9], v[110:111]
    v_cvt_pk_bf16_f32 v61, v8, v9
    v_lshlrev_b32 v6, 16, v62
    v_and_b32 v7, s12, v62
    v_pk_mul_f32 v[6:7], v[6:7], v[10:11] op_sel_hi:[1,0]
    v_pk_mul_f32 v[6:7], v[6:7], v[112:113]
    v_cvt_pk_bf16_f32 v62, v6, v7
    v_lshlrev_b32 v8, 16, v63
    v_and_b32 v9, s12, v63
    v_pk_mul_f32 v[8:9], v[8:9], v[10:11] op_sel_hi:[1,0]
    v_pk_mul_f32 v[8:9], v[8:9], v[114:115]
    v_cvt_pk_bf16_f32 v63, v8, v9
    v_lshlrev_b32 v6, 16, v64
    v_and_b32 v7, s12, v64
    v_pk_mul_f32 v[6:7], v[6:7], v[10:11] op_sel_hi:[1,0]
    v_pk_mul_f32 v[6:7], v[6:7], v[116:117]
    v_cvt_pk_bf16_f32 v64, v6, v7
    v_lshlrev_b32 v8, 16, v65
    v_and_b32 v9, s12, v65
    v_pk_mul_f32 v[8:9], v[8:9], v[10:11] op_sel_hi:[1,0]
    v_pk_mul_f32 v[8:9], v[8:9], v[118:119]
    v_cvt_pk_bf16_f32 v65, v8, v9
    v_lshlrev_b32 v6, 16, v66
    v_and_b32 v7, s12, v66
    v_pk_mul_f32 v[6:7], v[6:7], v[10:11] op_sel_hi:[1,0]
    v_pk_mul_f32 v[6:7], v[6:7], v[120:121]
    v_cvt_pk_bf16_f32 v66, v6, v7
    v_lshlrev_b32 v8, 16, v67
    v_and_b32 v9, s12, v67
    v_pk_mul_f32 v[8:9], v[8:9], v[10:11] op_sel_hi:[1,0]
    v_pk_mul_f32 v[8:9], v[8:9], v[122:123]
    v_cvt_pk_bf16_f32 v67, v8, v9
    v_mov_b32 v8, 0
L_gate:
    ds_read_b32 v9, v8
    s_waitcnt lgkmcnt(0)
    v_cmp_gt_u32 vcc, 92, v9
    s_cbranch_vccnz L_gate
    global_store_dwordx4 v2, v[12:15], s[8:9] offset:0 sc0 sc1
    global_store_dwordx4 v2, v[16:19], s[8:9] offset:128 sc0 sc1
    global_store_dwordx4 v2, v[20:23], s[8:9] offset:256 sc0 sc1
    global_store_dwordx4 v2, v[24:27], s[8:9] offset:384 sc0 sc1
    global_store_dwordx4 v2, v[28:31], s[8:9] offset:512 sc0 sc1
    global_store_dwordx4 v2, v[32:35], s[8:9] offset:640 sc0 sc1
    global_store_dwordx4 v2, v[36:39], s[8:9] offset:768 sc0 sc1
    global_store_dwordx4 v3, v[40:43], s[8:9] offset:0 sc0 sc1 nt
    global_store_dwordx4 v3, v[44:47], s[8:9] offset:128 sc0 sc1 nt
    global_store_dwordx4 v3, v[48:51], s[8:9] offset:256 sc0 sc1 nt
    global_store_dwordx4 v3, v[52:55], s[8:9] offset:384 sc0 sc1 nt
    global_store_dwordx4 v3, v[56:59], s[8:9] offset:512 sc0 sc1 nt
    global_store_dwordx4 v3, v[60:63], s[8:9] offset:640 sc0 sc1 nt
    global_store_dwordx4 v3, v[64:67], s[8:9] offset:768 sc0 sc1 nt
L_end:
    s_endpgm
.section .rodata,"a"
.p2align 6
.amdhsa_kernel standalone__rmsnorm__sampling_kernel
  .amdhsa_next_free_vgpr 124
  .amdhsa_next_free_sgpr 16
  .amdhsa_accum_offset 124
  .amdhsa_group_segment_fixed_size 0
  .amdhsa_kernarg_size 40
  .amdhsa_user_sgpr_count 2
  .amdhsa_user_sgpr_kernarg_segment_ptr 1
  .amdhsa_system_sgpr_workgroup_id_x 1
  .amdhsa_float_denorm_mode_32 3
.end_amdhsa_kernel
```
